```python
import torch

def _softmax(x, axis=-1):
    return torch.softmax(x, dim=axis)
def _gelu(x):
    return torch.nn.functional.gelu(x, approximate="tanh")
def _silu(x):
    return torch.nn.functional.silu(x)
def _sigmoid(x):
    return torch.sigmoid(x)
def _layernorm(x, axis=-1, eps=1e-5):
    m = x.mean(dim=axis, keepdim=True)
    v = x.var(dim=axis, keepdim=True, unbiased=False)
    return (x - m) / torch.sqrt(v + eps)
def _scatter_add(tgt, idx, src, axis=0):
    return tgt.clone().index_add_(axis, idx, src)
def _segment_sum(src, seg, n):
    out = torch.zeros((n,) + src.shape[1:], dtype=src.dtype)
    return out.index_add_(0, seg, src)
def _pad(x, pw):
    flat = tuple(v for pair in reversed(pw) for v in pair)
    return torch.nn.functional.pad(x, flat)

kernel_name = 'standalone__grn__sampling'

def setup_inputs():

    _w = (lambda a: (lambda t: t.to(torch.bfloat16) if t.is_floating_point() else t)(torch.as_tensor(a)))
    B, S, D = 1024, 16, 448
    return {
        "x": _w((lambda *s: torch.randn(*s, dtype=torch.bfloat16) * 0.05)(B, S, D)),
        "g": _w((lambda *s: torch.randn(*s, dtype=torch.bfloat16) * 0.4)(D) * 0.1),
        "b": _w((lambda *s: torch.randn(*s, dtype=torch.bfloat16) * 0.1)(D) * 0.1),
    }

def reference(x, g, b):
    gx = torch.sqrt((x * x).sum(axis=-2, keepdims=True))
    nx = gx / (gx.mean(axis=-1, keepdims=True) + 1e-6)
    return g * (x * nx) + b + x
```

```asm
; @launch grid=(256,1,1) block=(256,1,1) lds=0
.amdgcn_target "amdgcn-amd-amdhsa--gfx950"
.text
.globl standalone__grn__sampling_kernel
.p2align 8
.type standalone__grn__sampling_kernel,@function
standalone__grn__sampling_kernel:
    s_load_dwordx8 s[4:11], s[0:1], 0
    v_lshrrev_b32 v1, 6, v0
    v_and_b32 v0, 63, v0
    v_readfirstlane_b32 s3, v1
    s_lshl_b32 s2, s2, 2
    s_add_u32 s2, s2, s3
    s_cmp_ge_u32 s2, 1024
    s_cbranch_scc1 L_end
    s_mul_i32 s3, s2, 14336
    s_add_u32 s3, s3, 4096
    v_lshlrev_b32 v3, 4, v0
    v_add_u32 v1, s3, v3
    v_add_u32 v2, 0x1f80, v1
    s_mov_b32 s12, 0xffff0000
    v_mov_b32 v4, 0x358637bd
    v_mov_b32 v5, 0x3b124925
    v_mov_b32 v6, 1.0
    v_mov_b32 v0, 0
    s_mov_b32 exec_hi, 0x00ffffff
    s_waitcnt lgkmcnt(0)
    global_load_dwordx4 v[8:11], v1, s[4:5] offset:-4096 nt
    global_load_dwordx4 v[12:15], v1, s[4:5] offset:-3200 nt
    global_load_dwordx4 v[16:19], v1, s[4:5] offset:-2304 nt
    global_load_dwordx4 v[20:23], v1, s[4:5] offset:-1408 nt
    global_load_dwordx4 v[72:75], v3, s[6:7]
    global_load_dwordx4 v[76:79], v3, s[8:9]
    global_load_dwordx4 v[24:27], v1, s[4:5] offset:-512 nt
    global_load_dwordx4 v[28:31], v1, s[4:5] offset:384 nt
    global_load_dwordx4 v[32:35], v1, s[4:5] offset:1280 nt
    global_load_dwordx4 v[36:39], v1, s[4:5] offset:2176 nt
    global_load_dwordx4 v[40:43], v1, s[4:5] offset:3072 nt
    global_load_dwordx4 v[44:47], v2, s[4:5] offset:-4096 nt
    global_load_dwordx4 v[48:51], v2, s[4:5] offset:-3200 nt
    global_load_dwordx4 v[52:55], v2, s[4:5] offset:-2304 nt
    global_load_dwordx4 v[56:59], v2, s[4:5] offset:-1408 nt
    global_load_dwordx4 v[60:63], v2, s[4:5] offset:-512 nt
    global_load_dwordx4 v[64:67], v2, s[4:5] offset:384 nt
    global_load_dwordx4 v[68:71], v2, s[4:5] offset:1280 nt
    s_waitcnt vmcnt(17)
    v_lshlrev_b32 v104, 16, v8
    v_and_b32 v105, s12, v8
    v_lshlrev_b32 v106, 16, v9
    v_and_b32 v107, s12, v9
    v_lshlrev_b32 v108, 16, v10
    v_and_b32 v109, s12, v10
    v_lshlrev_b32 v110, 16, v11
    v_and_b32 v111, s12, v11
    v_pk_mul_f32 v[80:81], v[104:105], v[104:105]
    v_pk_mul_f32 v[82:83], v[106:107], v[106:107]
    v_pk_mul_f32 v[84:85], v[108:109], v[108:109]
    v_pk_mul_f32 v[86:87], v[110:111], v[110:111]
    s_waitcnt vmcnt(16)
    v_lshlrev_b32 v112, 16, v12
    v_and_b32 v113, s12, v12
    v_lshlrev_b32 v114, 16, v13
    v_and_b32 v115, s12, v13
    v_lshlrev_b32 v116, 16, v14
    v_and_b32 v117, s12, v14
    v_lshlrev_b32 v118, 16, v15
    v_and_b32 v119, s12, v15
    v_pk_fma_f32 v[80:81], v[112:113], v[112:113], v[80:81]
    v_pk_fma_f32 v[82:83], v[114:115], v[114:115], v[82:83]
    v_pk_fma_f32 v[84:85], v[116:117], v[116:117], v[84:85]
    v_pk_fma_f32 v[86:87], v[118:119], v[118:119], v[86:87]
    s_waitcnt vmcnt(15)
    v_lshlrev_b32 v120, 16, v16
    v_and_b32 v121, s12, v16
    v_lshlrev_b32 v122, 16, v17
    v_and_b32 v123, s12, v17
    v_lshlrev_b32 v124, 16, v18
    v_and_b32 v125, s12, v18
    v_lshlrev_b32 v126, 16, v19
    v_and_b32 v127, s12, v19
    v_pk_fma_f32 v[80:81], v[120:121], v[120:121], v[80:81]
    v_pk_fma_f32 v[82:83], v[122:123], v[122:123], v[82:83]
    v_pk_fma_f32 v[84:85], v[124:125], v[124:125], v[84:85]
    v_pk_fma_f32 v[86:87], v[126:127], v[126:127], v[86:87]
    s_waitcnt vmcnt(14)
    v_lshlrev_b32 v128, 16, v20
    v_and_b32 v129, s12, v20
    v_lshlrev_b32 v130, 16, v21
    v_and_b32 v131, s12, v21
    v_lshlrev_b32 v132, 16, v22
    v_and_b32 v133, s12, v22
    v_lshlrev_b32 v134, 16, v23
    v_and_b32 v135, s12, v23
    v_pk_fma_f32 v[80:81], v[128:129], v[128:129], v[80:81]
    v_pk_fma_f32 v[82:83], v[130:131], v[130:131], v[82:83]
    v_pk_fma_f32 v[84:85], v[132:133], v[132:133], v[84:85]
    v_pk_fma_f32 v[86:87], v[134:135], v[134:135], v[86:87]
    s_waitcnt vmcnt(11)
    v_lshlrev_b32 v136, 16, v24
    v_and_b32 v137, s12, v24
    v_lshlrev_b32 v138, 16, v25
    v_and_b32 v139, s12, v25
    v_lshlrev_b32 v140, 16, v26
    v_and_b32 v141, s12, v26
    v_lshlrev_b32 v142, 16, v27
    v_and_b32 v143, s12, v27
    v_pk_fma_f32 v[80:81], v[136:137], v[136:137], v[80:81]
    v_pk_fma_f32 v[82:83], v[138:139], v[138:139], v[82:83]
    v_pk_fma_f32 v[84:85], v[140:141], v[140:141], v[84:85]
    v_pk_fma_f32 v[86:87], v[142:143], v[142:143], v[86:87]
    v_lshlrev_b32 v88, 16, v72
    v_and_b32 v89, s12, v72
    v_lshlrev_b32 v90, 16, v73
    v_and_b32 v91, s12, v73
    v_lshlrev_b32 v92, 16, v74
    v_and_b32 v93, s12, v74
    v_lshlrev_b32 v94, 16, v75
    v_and_b32 v95, s12, v75
    v_lshlrev_b32 v96, 16, v76
    v_and_b32 v97, s12, v76
    v_lshlrev_b32 v98, 16, v77
    v_and_b32 v99, s12, v77
    v_lshlrev_b32 v100, 16, v78
    v_and_b32 v101, s12, v78
    v_lshlrev_b32 v102, 16, v79
    v_and_b32 v103, s12, v79
    s_waitcnt vmcnt(10)
    v_lshlrev_b32 v144, 16, v28
    v_and_b32 v145, s12, v28
    v_lshlrev_b32 v146, 16, v29
    v_and_b32 v147, s12, v29
    v_lshlrev_b32 v148, 16, v30
    v_and_b32 v149, s12, v30
    v_lshlrev_b32 v150, 16, v31
    v_and_b32 v151, s12, v31
    v_pk_fma_f32 v[80:81], v[144:145], v[144:145], v[80:81]
    v_pk_fma_f32 v[82:83], v[146:147], v[146:147], v[82:83]
    v_pk_fma_f32 v[84:85], v[148:149], v[148:149], v[84:85]
    v_pk_fma_f32 v[86:87], v[150:151], v[150:151], v[86:87]
    s_waitcnt vmcnt(9)
    v_lshlrev_b32 v152, 16, v32
    v_and_b32 v153, s12, v32
    v_lshlrev_b32 v154, 16, v33
    v_and_b32 v155, s12, v33
    v_lshlrev_b32 v156, 16, v34
    v_and_b32 v157, s12, v34
    v_lshlrev_b32 v158, 16, v35
    v_and_b32 v159, s12, v35
    v_pk_fma_f32 v[80:81], v[152:153], v[152:153], v[80:81]
    v_pk_fma_f32 v[82:83], v[154:155], v[154:155], v[82:83]
    v_pk_fma_f32 v[84:85], v[156:157], v[156:157], v[84:85]
    v_pk_fma_f32 v[86:87], v[158:159], v[158:159], v[86:87]
    s_waitcnt vmcnt(8)
    v_lshlrev_b32 v160, 16, v36
    v_and_b32 v161, s12, v36
    v_lshlrev_b32 v162, 16, v37
    v_and_b32 v163, s12, v37
    v_lshlrev_b32 v164, 16, v38
    v_and_b32 v165, s12, v38
    v_lshlrev_b32 v166, 16, v39
    v_and_b32 v167, s12, v39
    v_pk_fma_f32 v[80:81], v[160:161], v[160:161], v[80:81]
    v_pk_fma_f32 v[82:83], v[162:163], v[162:163], v[82:83]
    v_pk_fma_f32 v[84:85], v[164:165], v[164:165], v[84:85]
    v_pk_fma_f32 v[86:87], v[166:167], v[166:167], v[86:87]
    s_waitcnt vmcnt(7)
    v_lshlrev_b32 v168, 16, v40
    v_and_b32 v169, s12, v40
    v_lshlrev_b32 v170, 16, v41
    v_and_b32 v171, s12, v41
    v_lshlrev_b32 v172, 16, v42
    v_and_b32 v173, s12, v42
    v_lshlrev_b32 v174, 16, v43
    v_and_b32 v175, s12, v43
    v_pk_fma_f32 v[80:81], v[168:169], v[168:169], v[80:81]
    v_pk_fma_f32 v[82:83], v[170:171], v[170:171], v[82:83]
    v_pk_fma_f32 v[84:85], v[172:173], v[172:173], v[84:85]
    v_pk_fma_f32 v[86:87], v[174:175], v[174:175], v[86:87]
    s_waitcnt vmcnt(6)
    v_lshlrev_b32 v176, 16, v44
    v_and_b32 v177, s12, v44
    v_lshlrev_b32 v178, 16, v45
    v_and_b32 v179, s12, v45
    v_lshlrev_b32 v180, 16, v46
    v_and_b32 v181, s12, v46
    v_lshlrev_b32 v182, 16, v47
    v_and_b32 v183, s12, v47
    v_pk_fma_f32 v[80:81], v[176:177], v[176:177], v[80:81]
    v_pk_fma_f32 v[82:83], v[178:179], v[178:179], v[82:83]
    v_pk_fma_f32 v[84:85], v[180:181], v[180:181], v[84:85]
    v_pk_fma_f32 v[86:87], v[182:183], v[182:183], v[86:87]
    s_waitcnt vmcnt(5)
    v_lshlrev_b32 v184, 16, v48
    v_and_b32 v185, s12, v48
    v_lshlrev_b32 v186, 16, v49
    v_and_b32 v187, s12, v49
    v_lshlrev_b32 v188, 16, v50
    v_and_b32 v189, s12, v50
    v_lshlrev_b32 v190, 16, v51
    v_and_b32 v191, s12, v51
    v_pk_fma_f32 v[80:81], v[184:185], v[184:185], v[80:81]
    v_pk_fma_f32 v[82:83], v[186:187], v[186:187], v[82:83]
    v_pk_fma_f32 v[84:85], v[188:189], v[188:189], v[84:85]
    v_pk_fma_f32 v[86:87], v[190:191], v[190:191], v[86:87]
    s_waitcnt vmcnt(4)
    v_lshlrev_b32 v192, 16, v52
    v_and_b32 v193, s12, v52
    v_lshlrev_b32 v194, 16, v53
    v_and_b32 v195, s12, v53
    v_lshlrev_b32 v196, 16, v54
    v_and_b32 v197, s12, v54
    v_lshlrev_b32 v198, 16, v55
    v_and_b32 v199, s12, v55
    v_pk_fma_f32 v[80:81], v[192:193], v[192:193], v[80:81]
    v_pk_fma_f32 v[82:83], v[194:195], v[194:195], v[82:83]
    v_pk_fma_f32 v[84:85], v[196:197], v[196:197], v[84:85]
    v_pk_fma_f32 v[86:87], v[198:199], v[198:199], v[86:87]
    s_waitcnt vmcnt(3)
    v_lshlrev_b32 v200, 16, v56
    v_and_b32 v201, s12, v56
    v_lshlrev_b32 v202, 16, v57
    v_and_b32 v203, s12, v57
    v_lshlrev_b32 v204, 16, v58
    v_and_b32 v205, s12, v58
    v_lshlrev_b32 v206, 16, v59
    v_and_b32 v207, s12, v59
    v_pk_fma_f32 v[80:81], v[200:201], v[200:201], v[80:81]
    v_pk_fma_f32 v[82:83], v[202:203], v[202:203], v[82:83]
    v_pk_fma_f32 v[84:85], v[204:205], v[204:205], v[84:85]
    v_pk_fma_f32 v[86:87], v[206:207], v[206:207], v[86:87]
    s_waitcnt vmcnt(2)
    v_lshlrev_b32 v208, 16, v60
    v_and_b32 v209, s12, v60
    v_lshlrev_b32 v210, 16, v61
    v_and_b32 v211, s12, v61
    v_lshlrev_b32 v212, 16, v62
    v_and_b32 v213, s12, v62
    v_lshlrev_b32 v214, 16, v63
    v_and_b32 v215, s12, v63
    v_pk_fma_f32 v[80:81], v[208:209], v[208:209], v[80:81]
    v_pk_fma_f32 v[82:83], v[210:211], v[210:211], v[82:83]
    v_pk_fma_f32 v[84:85], v[212:213], v[212:213], v[84:85]
    v_pk_fma_f32 v[86:87], v[214:215], v[214:215], v[86:87]
    s_waitcnt vmcnt(1)
    v_lshlrev_b32 v216, 16, v64
    v_and_b32 v217, s12, v64
    v_lshlrev_b32 v218, 16, v65
    v_and_b32 v219, s12, v65
    v_lshlrev_b32 v220, 16, v66
    v_and_b32 v221, s12, v66
    v_lshlrev_b32 v222, 16, v67
    v_and_b32 v223, s12, v67
    v_pk_fma_f32 v[80:81], v[216:217], v[216:217], v[80:81]
    v_pk_fma_f32 v[82:83], v[218:219], v[218:219], v[82:83]
    v_pk_fma_f32 v[84:85], v[220:221], v[220:221], v[84:85]
    v_pk_fma_f32 v[86:87], v[222:223], v[222:223], v[86:87]
    s_waitcnt vmcnt(0)
    v_lshlrev_b32 v224, 16, v68
    v_and_b32 v225, s12, v68
    v_lshlrev_b32 v226, 16, v69
    v_and_b32 v227, s12, v69
    v_lshlrev_b32 v228, 16, v70
    v_and_b32 v229, s12, v70
    v_lshlrev_b32 v230, 16, v71
    v_and_b32 v231, s12, v71
    v_pk_fma_f32 v[80:81], v[224:225], v[224:225], v[80:81]
    v_pk_fma_f32 v[82:83], v[226:227], v[226:227], v[82:83]
    v_pk_fma_f32 v[84:85], v[228:229], v[228:229], v[84:85]
    v_pk_fma_f32 v[86:87], v[230:231], v[230:231], v[86:87]
    v_sqrt_f32 v80, v80
    v_sqrt_f32 v81, v81
    v_sqrt_f32 v82, v82
    v_sqrt_f32 v83, v83
    v_sqrt_f32 v84, v84
    v_sqrt_f32 v85, v85
    v_sqrt_f32 v86, v86
    v_sqrt_f32 v87, v87
    s_nop 0
    v_pk_add_f32 v[8:9], v[80:81], v[82:83]
    v_pk_add_f32 v[10:11], v[84:85], v[86:87]
    v_pk_add_f32 v[8:9], v[8:9], v[10:11]
    v_add_f32 v0, v8, v9
    s_mov_b32 exec_hi, -1
    s_nop 0
    v_add_f32_dpp v0, v0, v0 row_shr:1 row_mask:0xf bank_mask:0xf bound_ctrl:1
    v_pk_mul_f32 v[80:81], v[80:81], v[88:89]
    s_nop 0
    v_add_f32_dpp v0, v0, v0 row_shr:2 row_mask:0xf bank_mask:0xf bound_ctrl:1
    v_pk_mul_f32 v[82:83], v[82:83], v[90:91]
    s_nop 0
    v_add_f32_dpp v0, v0, v0 row_shr:4 row_mask:0xf bank_mask:0xf bound_ctrl:1
    v_pk_mul_f32 v[84:85], v[84:85], v[92:93]
    s_nop 0
    v_add_f32_dpp v0, v0, v0 row_shr:8 row_mask:0xf bank_mask:0xf bound_ctrl:1
    v_pk_mul_f32 v[86:87], v[86:87], v[94:95]
    s_nop 0
    v_add_f32_dpp v0, v0, v0 row_bcast:15 row_mask:0xa bank_mask:0xf
    s_nop 1
    v_add_f32_dpp v0, v0, v0 row_bcast:31 row_mask:0xc bank_mask:0xf
    s_nop 0
    v_readlane_b32 s13, v0, 63
    s_mov_b32 exec_hi, 0x00ffffff
    s_nop 0
    v_fma_f32 v4, s13, v5, v4
    v_rcp_f32 v4, v4
    s_nop 0
    v_pk_fma_f32 v[80:81], v[80:81], v[4:5], v[6:7] op_sel_hi:[1,0,0]
    v_pk_fma_f32 v[82:83], v[82:83], v[4:5], v[6:7] op_sel_hi:[1,0,0]
    v_pk_fma_f32 v[84:85], v[84:85], v[4:5], v[6:7] op_sel_hi:[1,0,0]
    v_pk_fma_f32 v[86:87], v[86:87], v[4:5], v[6:7] op_sel_hi:[1,0,0]
    v_pk_fma_f32 v[104:105], v[104:105], v[80:81], v[96:97]
    v_pk_fma_f32 v[106:107], v[106:107], v[82:83], v[98:99]
    v_pk_fma_f32 v[108:109], v[108:109], v[84:85], v[100:101]
    v_pk_fma_f32 v[110:111], v[110:111], v[86:87], v[102:103]
    v_cvt_pk_bf16_f32 v8, v104, v105
    v_cvt_pk_bf16_f32 v9, v106, v107
    v_cvt_pk_bf16_f32 v10, v108, v109
    v_cvt_pk_bf16_f32 v11, v110, v111
    global_store_dwordx4 v1, v[8:11], s[10:11] offset:-4096 sc0 sc1 nt
    v_pk_fma_f32 v[112:113], v[112:113], v[80:81], v[96:97]
    v_pk_fma_f32 v[114:115], v[114:115], v[82:83], v[98:99]
    v_pk_fma_f32 v[116:117], v[116:117], v[84:85], v[100:101]
    v_pk_fma_f32 v[118:119], v[118:119], v[86:87], v[102:103]
    v_cvt_pk_bf16_f32 v12, v112, v113
    v_cvt_pk_bf16_f32 v13, v114, v115
    v_cvt_pk_bf16_f32 v14, v116, v117
    v_cvt_pk_bf16_f32 v15, v118, v119
    global_store_dwordx4 v1, v[12:15], s[10:11] offset:-3200 sc0 sc1 nt
    v_pk_fma_f32 v[120:121], v[120:121], v[80:81], v[96:97]
    v_pk_fma_f32 v[122:123], v[122:123], v[82:83], v[98:99]
    v_pk_fma_f32 v[124:125], v[124:125], v[84:85], v[100:101]
    v_pk_fma_f32 v[126:127], v[126:127], v[86:87], v[102:103]
    v_cvt_pk_bf16_f32 v16, v120, v121
    v_cvt_pk_bf16_f32 v17, v122, v123
    v_cvt_pk_bf16_f32 v18, v124, v125
    v_cvt_pk_bf16_f32 v19, v126, v127
    global_store_dwordx4 v1, v[16:19], s[10:11] offset:-2304 sc0 sc1 nt
    v_pk_fma_f32 v[128:129], v[128:129], v[80:81], v[96:97]
    v_pk_fma_f32 v[130:131], v[130:131], v[82:83], v[98:99]
    v_pk_fma_f32 v[132:133], v[132:133], v[84:85], v[100:101]
    v_pk_fma_f32 v[134:135], v[134:135], v[86:87], v[102:103]
    v_cvt_pk_bf16_f32 v20, v128, v129
    v_cvt_pk_bf16_f32 v21, v130, v131
    v_cvt_pk_bf16_f32 v22, v132, v133
    v_cvt_pk_bf16_f32 v23, v134, v135
    global_store_dwordx4 v1, v[20:23], s[10:11] offset:-1408 sc0 sc1 nt
    v_pk_fma_f32 v[136:137], v[136:137], v[80:81], v[96:97]
    v_pk_fma_f32 v[138:139], v[138:139], v[82:83], v[98:99]
    v_pk_fma_f32 v[140:141], v[140:141], v[84:85], v[100:101]
    v_pk_fma_f32 v[142:143], v[142:143], v[86:87], v[102:103]
    v_cvt_pk_bf16_f32 v24, v136, v137
    v_cvt_pk_bf16_f32 v25, v138, v139
    v_cvt_pk_bf16_f32 v26, v140, v141
    v_cvt_pk_bf16_f32 v27, v142, v143
    global_store_dwordx4 v1, v[24:27], s[10:11] offset:-512 sc0 sc1 nt
    v_pk_fma_f32 v[144:145], v[144:145], v[80:81], v[96:97]
    v_pk_fma_f32 v[146:147], v[146:147], v[82:83], v[98:99]
    v_pk_fma_f32 v[148:149], v[148:149], v[84:85], v[100:101]
    v_pk_fma_f32 v[150:151], v[150:151], v[86:87], v[102:103]
    v_cvt_pk_bf16_f32 v28, v144, v145
    v_cvt_pk_bf16_f32 v29, v146, v147
    v_cvt_pk_bf16_f32 v30, v148, v149
    v_cvt_pk_bf16_f32 v31, v150, v151
    global_store_dwordx4 v1, v[28:31], s[10:11] offset:384 sc0 sc1 nt
    v_pk_fma_f32 v[152:153], v[152:153], v[80:81], v[96:97]
    v_pk_fma_f32 v[154:155], v[154:155], v[82:83], v[98:99]
    v_pk_fma_f32 v[156:157], v[156:157], v[84:85], v[100:101]
    v_pk_fma_f32 v[158:159], v[158:159], v[86:87], v[102:103]
    v_cvt_pk_bf16_f32 v32, v152, v153
    v_cvt_pk_bf16_f32 v33, v154, v155
    v_cvt_pk_bf16_f32 v34, v156, v157
    v_cvt_pk_bf16_f32 v35, v158, v159
    global_store_dwordx4 v1, v[32:35], s[10:11] offset:1280 sc0 sc1 nt
    v_pk_fma_f32 v[160:161], v[160:161], v[80:81], v[96:97]
    v_pk_fma_f32 v[162:163], v[162:163], v[82:83], v[98:99]
    v_pk_fma_f32 v[164:165], v[164:165], v[84:85], v[100:101]
    v_pk_fma_f32 v[166:167], v[166:167], v[86:87], v[102:103]
    v_cvt_pk_bf16_f32 v36, v160, v161
    v_cvt_pk_bf16_f32 v37, v162, v163
    v_cvt_pk_bf16_f32 v38, v164, v165
    v_cvt_pk_bf16_f32 v39, v166, v167
    global_store_dwordx4 v1, v[36:39], s[10:11] offset:2176 sc0 sc1 nt
    v_pk_fma_f32 v[168:169], v[168:169], v[80:81], v[96:97]
    v_pk_fma_f32 v[170:171], v[170:171], v[82:83], v[98:99]
    v_pk_fma_f32 v[172:173], v[172:173], v[84:85], v[100:101]
    v_pk_fma_f32 v[174:175], v[174:175], v[86:87], v[102:103]
    v_cvt_pk_bf16_f32 v40, v168, v169
    v_cvt_pk_bf16_f32 v41, v170, v171
    v_cvt_pk_bf16_f32 v42, v172, v173
    v_cvt_pk_bf16_f32 v43, v174, v175
    global_store_dwordx4 v1, v[40:43], s[10:11] offset:3072 sc0 sc1 nt
    v_pk_fma_f32 v[176:177], v[176:177], v[80:81], v[96:97]
    v_pk_fma_f32 v[178:179], v[178:179], v[82:83], v[98:99]
    v_pk_fma_f32 v[180:181], v[180:181], v[84:85], v[100:101]
    v_pk_fma_f32 v[182:183], v[182:183], v[86:87], v[102:103]
    v_cvt_pk_bf16_f32 v44, v176, v177
    v_cvt_pk_bf16_f32 v45, v178, v179
    v_cvt_pk_bf16_f32 v46, v180, v181
    v_cvt_pk_bf16_f32 v47, v182, v183
    global_store_dwordx4 v2, v[44:47], s[10:11] offset:-4096 sc0 sc1 nt
    v_pk_fma_f32 v[184:185], v[184:185], v[80:81], v[96:97]
    v_pk_fma_f32 v[186:187], v[186:187], v[82:83], v[98:99]
    v_pk_fma_f32 v[188:189], v[188:189], v[84:85], v[100:101]
    v_pk_fma_f32 v[190:191], v[190:191], v[86:87], v[102:103]
    v_cvt_pk_bf16_f32 v48, v184, v185
    v_cvt_pk_bf16_f32 v49, v186, v187
    v_cvt_pk_bf16_f32 v50, v188, v189
    v_cvt_pk_bf16_f32 v51, v190, v191
    global_store_dwordx4 v2, v[48:51], s[10:11] offset:-3200 sc0 sc1 nt
    v_pk_fma_f32 v[192:193], v[192:193], v[80:81], v[96:97]
    v_pk_fma_f32 v[194:195], v[194:195], v[82:83], v[98:99]
    v_pk_fma_f32 v[196:197], v[196:197], v[84:85], v[100:101]
    v_pk_fma_f32 v[198:199], v[198:199], v[86:87], v[102:103]
    v_cvt_pk_bf16_f32 v52, v192, v193
    v_cvt_pk_bf16_f32 v53, v194, v195
    v_cvt_pk_bf16_f32 v54, v196, v197
    v_cvt_pk_bf16_f32 v55, v198, v199
    global_store_dwordx4 v2, v[52:55], s[10:11] offset:-2304 sc0 sc1 nt
    v_pk_fma_f32 v[200:201], v[200:201], v[80:81], v[96:97]
    v_pk_fma_f32 v[202:203], v[202:203], v[82:83], v[98:99]
    v_pk_fma_f32 v[204:205], v[204:205], v[84:85], v[100:101]
    v_pk_fma_f32 v[206:207], v[206:207], v[86:87], v[102:103]
    v_cvt_pk_bf16_f32 v56, v200, v201
    v_cvt_pk_bf16_f32 v57, v202, v203
    v_cvt_pk_bf16_f32 v58, v204, v205
    v_cvt_pk_bf16_f32 v59, v206, v207
    global_store_dwordx4 v2, v[56:59], s[10:11] offset:-1408 sc0 sc1 nt
    v_pk_fma_f32 v[208:209], v[208:209], v[80:81], v[96:97]
    v_pk_fma_f32 v[210:211], v[210:211], v[82:83], v[98:99]
    v_pk_fma_f32 v[212:213], v[212:213], v[84:85], v[100:101]
    v_pk_fma_f32 v[214:215], v[214:215], v[86:87], v[102:103]
    v_cvt_pk_bf16_f32 v60, v208, v209
    v_cvt_pk_bf16_f32 v61, v210, v211
    v_cvt_pk_bf16_f32 v62, v212, v213
    v_cvt_pk_bf16_f32 v63, v214, v215
    global_store_dwordx4 v2, v[60:63], s[10:11] offset:-512 sc0 sc1 nt
    v_pk_fma_f32 v[216:217], v[216:217], v[80:81], v[96:97]
    v_pk_fma_f32 v[218:219], v[218:219], v[82:83], v[98:99]
    v_pk_fma_f32 v[220:221], v[220:221], v[84:85], v[100:101]
    v_pk_fma_f32 v[222:223], v[222:223], v[86:87], v[102:103]
    v_cvt_pk_bf16_f32 v64, v216, v217
    v_cvt_pk_bf16_f32 v65, v218, v219
    v_cvt_pk_bf16_f32 v66, v220, v221
    v_cvt_pk_bf16_f32 v67, v222, v223
    global_store_dwordx4 v2, v[64:67], s[10:11] offset:384 sc0 sc1 nt
    v_pk_fma_f32 v[224:225], v[224:225], v[80:81], v[96:97]
    v_pk_fma_f32 v[226:227], v[226:227], v[82:83], v[98:99]
    v_pk_fma_f32 v[228:229], v[228:229], v[84:85], v[100:101]
    v_pk_fma_f32 v[230:231], v[230:231], v[86:87], v[102:103]
    v_cvt_pk_bf16_f32 v68, v224, v225
    v_cvt_pk_bf16_f32 v69, v226, v227
    v_cvt_pk_bf16_f32 v70, v228, v229
    v_cvt_pk_bf16_f32 v71, v230, v231
    global_store_dwordx4 v2, v[68:71], s[10:11] offset:1280 sc0 sc1 nt
L_end:
    s_endpgm
.section .rodata,"a"
.p2align 6
.amdhsa_kernel standalone__grn__sampling_kernel
  .amdhsa_next_free_vgpr 232
  .amdhsa_next_free_sgpr 24
  .amdhsa_accum_offset 232
  .amdhsa_group_segment_fixed_size 0
  .amdhsa_kernarg_size 48
  .amdhsa_user_sgpr_count 2
  .amdhsa_user_sgpr_kernarg_segment_ptr 1
  .amdhsa_system_sgpr_workgroup_id_x 1
  .amdhsa_float_denorm_mode_32 3
.end_amdhsa_kernel
```
